```python
import torch

def _softmax(x, axis=-1):
    return torch.softmax(x, dim=axis)

def _gelu(x):
    return torch.nn.functional.gelu(x, approximate='tanh')

def _silu(x):
    return torch.nn.functional.silu(x)

def _sigmoid(x):
    return torch.sigmoid(x)

def _layernorm(x, axis=-1, eps=1e-05):
    m = x.mean(dim=axis, keepdim=True)
    v = x.var(dim=axis, keepdim=True, unbiased=False)
    return (x - m) / torch.sqrt(v + eps)

def _scatter_add(tgt, idx, src, axis=0):
    return tgt.clone().index_add_(axis, idx, src)

def _segment_sum(src, seg, n):
    out = torch.zeros((n,) + src.shape[1:], dtype=src.dtype)
    return out.index_add_(0, seg, src)

def _pad(x, pw):
    flat = tuple((v for pair in reversed(pw) for v in pair))
    return torch.nn.functional.pad(x, flat)
kernel_name = 'standalone__tree_speculative_verify_tree_attention_over_candidate_token_tree__decode'

def setup_inputs():

    _w = lambda a: (lambda t: t.to(torch.bfloat16) if t.is_floating_point() else t)(torch.as_tensor(a))
    B, Hq, Hkv, T, C, D = (8, 32, 8, 1, 8192, 128)
    tree_mask = torch.zeros((B, T, T), dtype=float)
    for b in range(B):
        parent = torch.zeros(T, dtype=torch.int64)
        for i in range(1, T):
            parent[i] = int(torch.randint(0, i, (1,)).item())
        for i in range(T):
            j = i
            tree_mask[b, i, j] = 1.0
            while j > 0:
                j = parent[j]
                tree_mask[b, i, j] = 1.0
    return {'q': _w((lambda *s: torch.randn(*s, dtype=torch.bfloat16) * 0.8)(B, Hq, T, D)), 'k_cache': _w((lambda *s: torch.randn(*s, dtype=torch.bfloat16) * 0.8)(B, Hkv, C, D)), 'v_cache': _w((lambda *s: torch.randn(*s, dtype=torch.bfloat16) * 0.05)(B, Hkv, C, D)), 'k_tree': _w((lambda *s: torch.randn(*s, dtype=torch.bfloat16) * 0.8)(B, Hkv, T, D)), 'v_tree': _w((lambda *s: torch.randn(*s, dtype=torch.bfloat16) * 0.05)(B, Hkv, T, D)), 'tree_mask': _w(tree_mask)}

def reference(q, k_cache, v_cache, k_tree, v_tree, tree_mask):
    B, Hq, T, D = q.shape
    Hkv, C = (k_cache.shape[1], k_cache.shape[2])
    rep = Hq // Hkv
    kc = (lambda x, n, axis: torch.repeat_interleave(x, n, dim=axis))(k_cache, rep, axis=1)
    vc = (lambda x, n, axis: torch.repeat_interleave(x, n, dim=axis))(v_cache, rep, axis=1)
    kt = (lambda x, n, axis: torch.repeat_interleave(x, n, dim=axis))(k_tree, rep, axis=1)
    vt = (lambda x, n, axis: torch.repeat_interleave(x, n, dim=axis))(v_tree, rep, axis=1)
    k = torch.concatenate([kc, kt], axis=2)
    v = torch.concatenate([vc, vt], axis=2)
    scale = D ** (-0.5)
    scores = torch.einsum('bhqd,bhkd->bhqk', q, k) * scale
    ctx_mask = torch.ones((B, 1, T, C), dtype=scores.dtype)
    tm = tree_mask[:, None, :, :].clone()
    full_mask = torch.concatenate([ctx_mask, tm], axis=-1)
    scores = scores + (1.0 - full_mask) * -1000000000.0
    p = _softmax(scores, axis=-1)
    return torch.einsum('bhqk,bhkd->bhqd', p, v)
```

```asm
; @launch grid=(256,1,1) block=(320,1,1) lds=109056
.amdgcn_target "amdgcn-amd-amdhsa--gfx950"
.text
.globl standalone__tree_speculative_verify_tree_attention_over_candidate_token_tree__decode_kernel
.p2align 8
.type standalone__tree_speculative_verify_tree_attention_over_candidate_token_tree__decode_kernel,@function
standalone__tree_speculative_verify_tree_attention_over_candidate_token_tree__decode_kernel:
    s_load_dwordx16 s[4:19], s[0:1], 0
    s_load_dwordx2 s[20:21], s[0:1], 64
    s_cmp_ge_u32 s2, 256
    s_cbranch_scc1 L_end
    s_bfe_u32 s3, s2, 0x30000
    s_bfe_u32 s44, s2, 0x30004
    s_lshl_b32 s44, s44, 3
    s_xor_b32 s3, s3, s44
    s_bfe_u32 s22, s2, 0x10003
    s_bfe_u32 s44, s2, 0x10007
    s_lshl_b32 s44, s44, 1
    s_xor_b32 s22, s22, s44
    v_lshrrev_b32 v17, 6, v0
    v_and_b32 v0, 63, v0
    v_readfirstlane_b32 s23, v17
    v_lshrrev_b32 v17, 4, v0
    v_and_b32 v18, 15, v0
    s_mov_b32 s42, 0x3e0293ee
    s_lshl_b32 s43, s3, 21
    s_cmp_eq_u32 s23, 4
    s_cbranch_scc1 L_helper
    v_lshlrev_b32 v19, 1, v17
    v_xor_b32 v19, v19, v18
    v_lshlrev_b32 v19, 4, v19
    v_lshl_add_u32 v1, v17, 8, v19
    v_xor_b32 v2, 0x80, v1
    s_bfe_u32 s38, s23, 0x20000
    s_lshl_b32 s38, s38, 13
    s_bfe_u32 s44, s22, 0x10000
    s_lshl_b32 s44, s44, 15
    s_xor_b32 s38, s38, s44
    s_bfe_u32 s44, s22, 0x10001
    s_lshl_b32 s44, s44, 20
    s_xor_b32 s38, s38, s44
    s_bfe_u32 s44, s22, 0x10001
    s_lshl_b32 s44, s44, 17
    s_xor_b32 s38, s38, s44
    s_bfe_u32 s44, s23, 0x10001
    s_lshl_b32 s44, s44, 18
    s_xor_b32 s38, s38, s44
    s_mov_b32 s40, 0
    s_mov_b32 s37, s38
    s_mul_i32 s36, s23, 16384
    s_mov_b32 s47, s36
    s_mov_b32 s26, 2097152
    s_mov_b32 s27, 0x20000
    s_mov_b32 s30, 2097152
    v_and_b32 v149, 3, v0
    v_lshlrev_b32 v148, 8, v149
    v_lshl_add_u32 v148, v17, 4, v148
    s_lshl_b32 s44, s3, 10
    v_add_u32 v148, s44, v148
    s_add_u32 m0, s47, 0
    s_xor_b32 s39, s37, 0x0
    s_waitcnt lgkmcnt(0)
    s_add_u32 s24, s6, s43
    s_addc_u32 s25, s7, 0
    buffer_load_dwordx4 v1, s[24:27], s39 offen nt lds
    global_load_dwordx4 v[20:23], v148, s[4:5] offset:0
    global_load_dwordx4 v[24:27], v148, s[4:5] offset:64
    global_load_dwordx4 v[28:31], v148, s[4:5] offset:128
    global_load_dwordx4 v[32:35], v148, s[4:5] offset:192
    s_add_u32 s28, s8, s43
    s_addc_u32 s29, s9, 0
    buffer_load_dwordx4 v2, s[24:27], s39 offen offset:1024 nt lds
    buffer_load_dwordx4 v1, s[24:27], s39 offen offset:2048 nt lds
    buffer_load_dwordx4 v2, s[24:27], s39 offen offset:3072 nt lds
    s_add_u32 m0, s47, 4096
    s_xor_b32 s39, s37, 0x1000
    buffer_load_dwordx4 v1, s[24:27], s39 offen nt lds
    v_and_b32 v153, 7, v0
    v_lshlrev_b32 v153, 1, v153
    v_xor_b32 v153, v153, v17
    v_lshlrev_b32 v153, 4, v153
    v_lshl_add_u32 v153, v18, 8, v153
    v_add_u32 v5, s36, v153
    v_xor_b32 v6, 0x40, v5
    v_xor_b32 v7, 0x80, v5
    v_xor_b32 v8, 0xc0, v5
    v_lshrrev_b32 v153, 2, v0
    v_and_b32 v154, 7, v153
    v_lshlrev_b32 v154, 5, v154
    v_lshl_add_u32 v154, v153, 8, v154
    v_lshl_add_u32 v154, v149, 3, v154
    v_add_u32 v9, s36, v154
    v_xor_b32 v10, 0x20, v9
    v_xor_b32 v11, 0x40, v9
    v_xor_b32 v12, 0x60, v9
    v_xor_b32 v13, 0x80, v9
    v_xor_b32 v14, 0xa0, v9
    v_xor_b32 v15, 0xc0, v9
    v_xor_b32 v16, 0xe0, v9
    s_mul_i32 s44, s23, 2112
    s_add_u32 s44, s44, 65536
    v_mul_u32_u24 v156, 528, v18
    v_lshl_add_u32 v156, v17, 4, v156
    v_add_u32 v156, s44, v156
    s_lshl_b32 s44, s23, 2
    v_lshlrev_b32 v157, 4, v149
    v_add_u32 v157, s44, v157
    v_add_u32 v157, 76224, v157
    v_lshlrev_b32 v167, 5, v149
    v_add_u32 v167, 76096, v167
    v_add_u32 v166, s44, v167
    s_lshl_b32 s44, s23, 13
    s_add_u32 s44, s44, 76288
    v_lshlrev_b32 v165, 5, v149
    v_lshl_add_u32 v165, v17, 7, v165
    v_add_u32 v165, s44, v165
    v_lshlrev_b32 v3, 4, v0
    v_lshlrev_b32 v4, 3, v17
    v_add_u32 v4, 2048, v4
    v_add_u32 v162, 73984, v3
    v_mov_b32 v163, 76032
    v_lshlrev_b32 v168, 5, v17
    v_add_u32 v168, 76096, v168
    v_mul_u32_u24 v160, 528, v17
    v_lshl_add_u32 v160, v18, 5, v160
    v_add_u32 v160, 65536, v160
    v_lshlrev_b32 v161, 4, v17
    v_add_u32 v161, 76224, v161
    s_lshl_b32 s43, s3, 14
    s_add_u32 s44, s22, 0
    s_and_b32 s44, s44, 3
    s_lshl_b32 s44, s44, 12
    s_add_u32 s44, s44, s43
    s_add_u32 s72, s20, s44
    s_addc_u32 s73, s21, 0
    s_add_u32 s44, s22, 1
    s_and_b32 s44, s44, 3
    s_lshl_b32 s44, s44, 12
    s_add_u32 s44, s44, s43
    s_add_u32 s74, s20, s44
    s_addc_u32 s75, s21, 0
    s_add_u32 s44, s22, 2
    s_and_b32 s44, s44, 3
    s_lshl_b32 s44, s44, 12
    s_add_u32 s44, s44, s43
    s_add_u32 s76, s20, s44
    s_addc_u32 s77, s21, 0
    s_add_u32 s44, s22, 3
    s_and_b32 s44, s44, 3
    s_lshl_b32 s44, s44, 12
    s_add_u32 s44, s44, s43
    s_add_u32 s78, s20, s44
    s_addc_u32 s79, s21, 0
    s_lshl_b32 s44, s3, 2
    s_add_u32 s82, s18, s44
    s_addc_u32 s83, s19, 0
    s_lshl_b32 s43, s3, 10
    s_add_u32 s80, s16, s43
    s_addc_u32 s81, s17, 0
    v_mov_b32 v164, 1
    v_mov_b32 v112, 0
    v_mov_b32 v113, 0
    v_mov_b32 v114, 0
    v_mov_b32 v115, 0
    v_mov_b32 v116, 0
    v_mov_b32 v117, 0
    v_mov_b32 v118, 0
    v_mov_b32 v119, 0
    v_mov_b32 v120, 0
    v_mov_b32 v121, 0
    v_mov_b32 v122, 0
    v_mov_b32 v123, 0
    v_mov_b32 v124, 0
    v_mov_b32 v125, 0
    v_mov_b32 v126, 0
    v_mov_b32 v127, 0
    v_mov_b32 v128, 0
    v_mov_b32 v129, 0
    v_mov_b32 v130, 0
    v_mov_b32 v131, 0
    v_mov_b32 v132, 0
    v_mov_b32 v133, 0
    v_mov_b32 v134, 0
    v_mov_b32 v135, 0
    v_mov_b32 v136, 0
    v_mov_b32 v137, 0
    v_mov_b32 v138, 0
    v_mov_b32 v139, 0
    v_mov_b32 v140, 0
    v_mov_b32 v141, 0
    v_mov_b32 v142, 0
    v_mov_b32 v143, 0
    v_mov_b32 v144, 0xff800000
    v_mov_b32 v145, 0
    s_mov_b64 vcc, 0
    s_waitcnt vmcnt(4)
    buffer_load_dwordx4 v2, s[24:27], s39 offen offset:1024 nt lds
    s_waitcnt vmcnt(4)
    buffer_load_dwordx4 v1, s[24:27], s39 offen offset:2048 nt lds
    s_mov_b32 s41, 0
L_kloop:
    s_waitcnt vmcnt(5)
    buffer_load_dwordx4 v2, s[24:27], s39 offen offset:3072 nt lds
    s_or_b32 s40, s40, 0xfff0ffff
    s_add_u32 s40, s40, 1
    s_and_b32 s40, s40, 0xf0000
    s_cselect_b32 s24, s24, s28
    s_cselect_b32 s25, s25, s29
    s_cselect_b32 s26, s26, s30
    s_cselect_b32 s30, s30, 0
    s_xor_b32 s37, s38, s40
    s_xor_b32 s47, s47, 8192
    s_add_u32 m0, s47, 0
    s_xor_b32 s39, s37, 0x0
    s_waitcnt vmcnt(4)
    buffer_load_dwordx4 v1, s[24:27], s39 offen nt lds
    s_waitcnt vmcnt(4)
    buffer_load_dwordx4 v2, s[24:27], s39 offen offset:1024 nt lds
    s_waitcnt vmcnt(4)
    buffer_load_dwordx4 v1, s[24:27], s39 offen offset:2048 nt lds
    ds_read_b128 v[36:39], v5
    ds_read_b128 v[40:43], v6
    ds_read_b128 v[44:47], v7
    ds_read_b128 v[48:51], v8
    s_waitcnt lgkmcnt(0)
    v_mfma_f32_16x16x32_bf16 v[100:103], v[36:39], v[20:23], 0
    v_mfma_f32_16x16x32_bf16 v[100:103], v[40:43], v[24:27], v[100:103]
    v_mfma_f32_16x16x32_bf16 v[100:103], v[44:47], v[28:31], v[100:103]
    v_mfma_f32_16x16x32_bf16 v[100:103], v[48:51], v[32:35], v[100:103]
    s_waitcnt vmcnt(5)
    buffer_load_dwordx4 v2, s[24:27], s39 offen offset:3072 nt lds
    s_add_u32 m0, s47, 4096
    s_xor_b32 s39, s37, 0x1000
    s_waitcnt vmcnt(4)
    buffer_load_dwordx4 v1, s[24:27], s39 offen nt lds
    s_waitcnt vmcnt(4)
    buffer_load_dwordx4 v2, s[24:27], s39 offen offset:1024 nt lds
    s_waitcnt vmcnt(4)
    buffer_load_dwordx4 v1, s[24:27], s39 offen offset:2048 nt lds
    ds_read_b128 v[52:55], v5 offset:4096
    ds_read_b128 v[56:59], v6 offset:4096
    ds_read_b128 v[60:63], v7 offset:4096
    ds_read_b128 v[64:67], v8 offset:4096
    ds_write_b128 v165, v[100:103]
    v_max3_f32 v144, v144, v100, v101
    v_max3_f32 v144, v144, v102, v103
    s_waitcnt lgkmcnt(0)
    v_mfma_f32_16x16x32_bf16 v[104:107], v[52:55], v[20:23], 0
    v_mfma_f32_16x16x32_bf16 v[104:107], v[56:59], v[24:27], v[104:107]
    v_mfma_f32_16x16x32_bf16 v[104:107], v[60:63], v[28:31], v[104:107]
    v_mfma_f32_16x16x32_bf16 v[104:107], v[64:67], v[32:35], v[104:107]
    s_add_u32 s41, s41, 1
    v_xor_b32 v5, 0x2000, v5
    v_xor_b32 v6, 0x2000, v6
    v_xor_b32 v7, 0x2000, v7
    v_xor_b32 v8, 0x2000, v8
    s_cmp_lg_u32 s41, 16
    s_nop 1
    ds_write_b128 v165, v[104:107] offset:16
    v_max3_f32 v144, v144, v104, v105
    v_max3_f32 v144, v144, v106, v107
    v_add_u32 v165, 512, v165
    s_cbranch_scc1 L_kloop
    v_mov_b32 v148, v144
    s_nop 1
    v_permlane32_swap_b32 v144, v148
    v_max_f32 v144, v144, v148
    v_mov_b32 v148, v144
    s_nop 1
    v_permlane16_swap_b32 v144, v148
    v_max_f32 v144, v144, v148
    v_mul_f32 v144, s42, v144
    v_subrev_u32 v165, 8192, v165
    ds_write_b32 v166, v144
    s_waitcnt lgkmcnt(0)
    s_barrier
    ds_read_b128 v[148:151], v167
    ds_read_b32 v152, v167 offset:16
    ds_read_b128 v[100:103], v168
    ds_read_b32 v104, v168 offset:16
    ds_read_b128 v[20:23], v162
    ds_read_b128 v[24:27], v162 offset:1024
    s_mov_b32 s41, 16
    s_waitcnt lgkmcnt(0)
    v_max3_f32 v144, v148, v149, v150
    v_max3_f32 v144, v144, v151, v152
    v_max3_f32 v28, v100, v101, v102
    v_max3_f32 v28, v28, v103, v104
    v_sub_f32 v104, v104, v28
    v_exp_f32 v104, v104
    s_nop 0
    v_mov_b32 v29, v104
    v_pk_mul_f32 v[20:21], v[20:21], v[104:105] op_sel_hi:[1,0]
    v_pk_mul_f32 v[22:23], v[22:23], v[104:105] op_sel_hi:[1,0]
    v_pk_mul_f32 v[24:25], v[24:25], v[104:105] op_sel_hi:[1,0]
    v_pk_mul_f32 v[26:27], v[26:27], v[104:105] op_sel_hi:[1,0]
L_vloop:
    ds_read_b128 v[100:103], v165
    ds_read_b128 v[104:107], v165 offset:16
    ds_read_b32 v146, v163 offset:8
    s_cbranch_vccnz L_w1
    s_waitcnt vmcnt(5)
L_w1:
    s_waitcnt vmcnt(6)
    buffer_load_dwordx4 v2, s[24:27], s39 offen offset:3072 nt lds
    v_add_u32 v165, 512, v165
    s_waitcnt lgkmcnt(0)
    v_cmp_ge_u32 vcc, s41, v146
    v_fma_f32 v100, v100, s42, -v144
    v_fma_f32 v101, v101, s42, -v144
    v_fma_f32 v102, v102, s42, -v144
    v_fma_f32 v103, v103, s42, -v144
    v_fma_f32 v104, v104, s42, -v144
    v_fma_f32 v105, v105, s42, -v144
    v_fma_f32 v106, v106, s42, -v144
    v_fma_f32 v107, v107, s42, -v144
    v_exp_f32 v100, v100
    v_exp_f32 v101, v101
    v_exp_f32 v102, v102
    v_exp_f32 v103, v103
    v_exp_f32 v104, v104
    v_exp_f32 v105, v105
    v_exp_f32 v106, v106
    v_exp_f32 v107, v107
    s_or_b32 s40, s40, 0xfff0ffff
    s_add_u32 s40, s40, 1
    s_and_b32 s40, s40, 0xf0000
    s_cselect_b32 s24, s24, s28
    s_cselect_b32 s25, s25, s29
    s_cselect_b32 s26, s26, s30
    s_cselect_b32 s30, s30, 0
    s_xor_b32 s37, s38, s40
    s_xor_b32 s47, s47, 8192
    s_add_u32 m0, s47, 0
    s_xor_b32 s39, s37, 0x0
    s_cbranch_vccnz L_w2
    s_waitcnt vmcnt(4)
L_w2:
    s_waitcnt vmcnt(6)
    buffer_load_dwordx4 v1, s[24:27], s39 offen nt lds
    v_add_f32 v148, v100, v101
    v_add_f32 v149, v102, v103
    v_add_f32 v150, v104, v105
    v_add_f32 v151, v106, v107
    v_add_f32 v148, v148, v149
    v_add_f32 v150, v150, v151
    v_add_f32 v148, v148, v150
    v_add_f32 v145, v145, v148
    v_cvt_pk_bf16_f32 v108, v100, v101
    v_cvt_pk_bf16_f32 v109, v102, v103
    v_cvt_pk_bf16_f32 v110, v104, v105
    v_cvt_pk_bf16_f32 v111, v106, v107
    s_cbranch_vccnz L_w3
    s_waitcnt vmcnt(4)
L_w3:
    s_waitcnt vmcnt(6)
    buffer_load_dwordx4 v2, s[24:27], s39 offen offset:1024 nt lds
    v_mov_b32 v148, v145
    v_mov_b32 v149, v148
    s_nop 1
    v_permlane32_swap_b32 v148, v149
    v_add_f32 v148, v148, v149
    v_mov_b32 v149, v148
    s_nop 1
    v_permlane16_swap_b32 v148, v149
    v_add_f32 v148, v148, v149
    ds_write_b32 v157, v148
    s_cbranch_vccnz L_w4
    s_waitcnt vmcnt(4)
L_w4:
    s_waitcnt vmcnt(6)
    buffer_load_dwordx4 v1, s[24:27], s39 offen offset:2048 nt lds
    s_cmp_lg_u32 s41, 22
    s_cbranch_scc1 L_vb
    s_barrier
L_vb:
    ds_read_b64_tr_b16 v[68:69], v9
    ds_read_b64_tr_b16 v[72:73], v10
    ds_read_b64_tr_b16 v[76:77], v11
    ds_read_b64_tr_b16 v[80:81], v12
    ds_read_b64_tr_b16 v[84:85], v13
    ds_read_b64_tr_b16 v[88:89], v14
    ds_read_b64_tr_b16 v[92:93], v15
    ds_read_b64_tr_b16 v[96:97], v16
    s_waitcnt lgkmcnt(0)
    s_cbranch_vccnz L_w5
    s_waitcnt vmcnt(5)
L_w5:
    s_waitcnt vmcnt(6)
    buffer_load_dwordx4 v2, s[24:27], s39 offen offset:3072 nt lds
    s_add_u32 m0, s47, 4096
    s_xor_b32 s39, s37, 0x1000
    s_cbranch_vccnz L_w6
    s_waitcnt vmcnt(4)
L_w6:
    s_waitcnt vmcnt(6)
    buffer_load_dwordx4 v1, s[24:27], s39 offen nt lds
    s_cbranch_vccnz L_w7
    s_waitcnt vmcnt(4)
L_w7:
    s_waitcnt vmcnt(6)
    buffer_load_dwordx4 v2, s[24:27], s39 offen offset:1024 nt lds
    s_cbranch_vccnz L_w8
    s_waitcnt vmcnt(4)
L_w8:
    s_waitcnt vmcnt(6)
    ds_read_b64_tr_b16 v[70:71], v9 offset:4096
    ds_read_b64_tr_b16 v[74:75], v10 offset:4096
    ds_read_b64_tr_b16 v[78:79], v11 offset:4096
    ds_read_b64_tr_b16 v[82:83], v12 offset:4096
    ds_read_b64_tr_b16 v[86:87], v13 offset:4096
    ds_read_b64_tr_b16 v[90:91], v14 offset:4096
    ds_read_b64_tr_b16 v[94:95], v15 offset:4096
    ds_read_b64_tr_b16 v[98:99], v16 offset:4096
    buffer_load_dwordx4 v1, s[24:27], s39 offen offset:2048 nt lds
    s_add_u32 s41, s41, 1
    s_cmp_lg_u32 s41, 32
    s_waitcnt lgkmcnt(7)
    v_mfma_f32_16x16x32_bf16 v[112:115], v[68:71], v[108:111], v[112:115]
    v_xor_b32 v9, 0x2000, v9
    s_waitcnt lgkmcnt(6)
    v_mfma_f32_16x16x32_bf16 v[116:119], v[72:75], v[108:111], v[116:119]
    v_xor_b32 v10, 0x2000, v10
    s_waitcnt lgkmcnt(5)
    v_mfma_f32_16x16x32_bf16 v[120:123], v[76:79], v[108:111], v[120:123]
    v_xor_b32 v11, 0x2000, v11
    s_waitcnt lgkmcnt(4)
    v_mfma_f32_16x16x32_bf16 v[124:127], v[80:83], v[108:111], v[124:127]
    v_xor_b32 v12, 0x2000, v12
    s_waitcnt lgkmcnt(3)
    v_mfma_f32_16x16x32_bf16 v[128:131], v[84:87], v[108:111], v[128:131]
    v_xor_b32 v13, 0x2000, v13
    s_waitcnt lgkmcnt(2)
    v_mfma_f32_16x16x32_bf16 v[132:135], v[88:91], v[108:111], v[132:135]
    v_xor_b32 v14, 0x2000, v14
    s_waitcnt lgkmcnt(1)
    v_mfma_f32_16x16x32_bf16 v[136:139], v[92:95], v[108:111], v[136:139]
    v_xor_b32 v15, 0x2000, v15
    s_waitcnt lgkmcnt(0)
    v_mfma_f32_16x16x32_bf16 v[140:143], v[96:99], v[108:111], v[140:143]
    v_xor_b32 v16, 0x2000, v16
    s_cbranch_scc1 L_vloop
    s_mov_b32 exec_lo, 0x000f000f
    s_mov_b32 exec_hi, 0x000f000f
    ds_write_b128 v156, v[112:115] offset:0
    ds_write_b128 v156, v[116:119] offset:64
    ds_write_b128 v156, v[120:123] offset:128
    ds_write_b128 v156, v[124:127] offset:192
    ds_write_b128 v156, v[128:131] offset:256
    ds_write_b128 v156, v[132:135] offset:320
    ds_write_b128 v156, v[136:139] offset:384
    ds_write_b128 v156, v[140:143] offset:448
    s_mov_b64 exec, 1
    ds_add_rtn_u32 v164, v163, v164
    s_mov_b64 exec, -1
    ds_read_b32 v72, v163 offset:4
    ds_read_b128 v[68:71], v161
    ds_read_b128 v[36:39], v160 offset:0
    ds_read_b128 v[40:43], v160 offset:16
    ds_read_b128 v[44:47], v160 offset:2112
    ds_read_b128 v[48:51], v160 offset:2128
    s_waitcnt lgkmcnt(6)
    v_readfirstlane_b32 s43, v164
    ds_read_b128 v[52:55], v160 offset:4224
    ds_read_b128 v[56:59], v160 offset:4240
    ds_read_b128 v[60:63], v160 offset:6336
    ds_read_b128 v[64:67], v160 offset:6352
    s_cmp_lg_u32 s43, 3
    s_cbranch_scc1 L_fin
    s_waitcnt lgkmcnt(8)
    v_readfirstlane_b32 s45, v72
    v_pk_add_f32 v[68:69], v[68:69], v[70:71]
    v_add_f32 v29, v29, v68
    v_add_f32 v29, v29, v69
    s_waitcnt lgkmcnt(6)
    v_pk_add_f32 v[20:21], v[20:21], v[36:37]
    v_pk_add_f32 v[22:23], v[22:23], v[38:39]
    v_pk_add_f32 v[24:25], v[24:25], v[40:41]
    v_pk_add_f32 v[26:27], v[26:27], v[42:43]
    s_waitcnt lgkmcnt(4)
    v_pk_add_f32 v[20:21], v[20:21], v[44:45]
    v_pk_add_f32 v[22:23], v[22:23], v[46:47]
    v_pk_add_f32 v[24:25], v[24:25], v[48:49]
    v_pk_add_f32 v[26:27], v[26:27], v[50:51]
    s_waitcnt lgkmcnt(2)
    v_pk_add_f32 v[20:21], v[20:21], v[52:53]
    v_pk_add_f32 v[22:23], v[22:23], v[54:55]
    v_pk_add_f32 v[24:25], v[24:25], v[56:57]
    v_pk_add_f32 v[26:27], v[26:27], v[58:59]
    s_waitcnt lgkmcnt(0)
    v_pk_add_f32 v[20:21], v[20:21], v[60:61]
    v_pk_add_f32 v[22:23], v[22:23], v[62:63]
    v_pk_add_f32 v[24:25], v[24:25], v[64:65]
    v_pk_add_f32 v[26:27], v[26:27], v[66:67]
    s_cmp_lg_u32 s45, 3
    s_cbranch_scc1 L_far
    global_store_dwordx2 v4, v[28:29], s[72:73]
    global_store_dwordx4 v3, v[20:23], s[72:73]
    global_store_dwordx4 v3, v[24:27], s[72:73] offset:1024
L_look:
    s_waitcnt vmcnt(0)
    global_load_dwordx2 v[60:61], v4, s[74:75] sc1
    global_load_dwordx2 v[62:63], v4, s[76:77] sc1
    global_load_dwordx2 v[64:65], v4, s[78:79] sc1
    global_load_dwordx4 v[36:39], v3, s[74:75] sc1
    global_load_dwordx4 v[40:43], v3, s[74:75] offset:1024 sc1
    global_load_dwordx4 v[44:47], v3, s[76:77] sc1
    global_load_dwordx4 v[48:51], v3, s[76:77] offset:1024 sc1
    global_load_dwordx4 v[52:55], v3, s[78:79] sc1
    global_load_dwordx4 v[56:59], v3, s[78:79] offset:1024 sc1
    s_waitcnt vmcnt(6)
    v_max3_f32 v148, v60, v62, v64
    v_max_f32 v148, v148, v28
    v_max3_u32 v68, v60, v61, v62
    v_max3_u32 v69, v63, v64, v65
    v_sub_f32 v100, v28, v148
    v_sub_f32 v102, v60, v148
    v_sub_f32 v104, v62, v148
    v_sub_f32 v106, v64, v148
    v_exp_f32 v100, v100
    v_exp_f32 v102, v102
    v_exp_f32 v104, v104
    v_exp_f32 v106, v106
    s_nop 0
    v_mul_f32 v149, v100, v29
    v_mul_f32 v150, v102, v61
    v_mul_f32 v151, v104, v63
    v_mul_f32 v152, v106, v65
    v_add_f32 v149, v149, v151
    v_add_f32 v150, v150, v152
    v_add_f32 v149, v149, v150
    v_rcp_f32 v149, v149
    s_nop 0
    v_mul_f32 v100, v149, v100
    v_mul_f32 v102, v149, v102
    v_mul_f32 v104, v149, v104
    v_mul_f32 v106, v149, v106
    v_pk_mul_f32 v[112:113], v[20:21], v[100:101] op_sel_hi:[1,0]
    v_pk_mul_f32 v[114:115], v[22:23], v[100:101] op_sel_hi:[1,0]
    v_pk_mul_f32 v[116:117], v[24:25], v[100:101] op_sel_hi:[1,0]
    v_pk_mul_f32 v[118:119], v[26:27], v[100:101] op_sel_hi:[1,0]
    s_waitcnt vmcnt(4)
    v_max3_u32 v68, v68, v36, v37
    v_max3_u32 v69, v69, v38, v39
    v_max3_u32 v68, v68, v40, v41
    v_max3_u32 v69, v69, v42, v43
    v_pk_mul_f32 v[36:37], v[36:37], v[102:103] op_sel_hi:[1,0]
    v_pk_mul_f32 v[38:39], v[38:39], v[102:103] op_sel_hi:[1,0]
    v_pk_mul_f32 v[40:41], v[40:41], v[102:103] op_sel_hi:[1,0]
    v_pk_mul_f32 v[42:43], v[42:43], v[102:103] op_sel_hi:[1,0]
    s_waitcnt vmcnt(2)
    v_max3_u32 v68, v68, v44, v45
    v_max3_u32 v69, v69, v46, v47
    v_max3_u32 v68, v68, v48, v49
    v_max3_u32 v69, v69, v50, v51
    v_pk_mul_f32 v[44:45], v[44:45], v[104:105] op_sel_hi:[1,0]
    v_pk_mul_f32 v[46:47], v[46:47], v[104:105] op_sel_hi:[1,0]
    v_pk_mul_f32 v[48:49], v[48:49], v[104:105] op_sel_hi:[1,0]
    v_pk_mul_f32 v[50:51], v[50:51], v[104:105] op_sel_hi:[1,0]
    v_pk_add_f32 v[112:113], v[112:113], v[44:45]
    v_pk_add_f32 v[114:115], v[114:115], v[46:47]
    v_pk_add_f32 v[116:117], v[116:117], v[48:49]
    v_pk_add_f32 v[118:119], v[118:119], v[50:51]
    s_waitcnt vmcnt(0)
    v_max3_u32 v68, v68, v52, v53
    v_max3_u32 v69, v69, v54, v55
    v_max3_u32 v68, v68, v56, v57
    v_max3_u32 v69, v69, v58, v59
    v_pk_mul_f32 v[52:53], v[52:53], v[106:107] op_sel_hi:[1,0]
    v_pk_mul_f32 v[54:55], v[54:55], v[106:107] op_sel_hi:[1,0]
    v_pk_mul_f32 v[56:57], v[56:57], v[106:107] op_sel_hi:[1,0]
    v_pk_mul_f32 v[58:59], v[58:59], v[106:107] op_sel_hi:[1,0]
    v_pk_add_f32 v[36:37], v[36:37], v[52:53]
    v_pk_add_f32 v[38:39], v[38:39], v[54:55]
    v_pk_add_f32 v[40:41], v[40:41], v[56:57]
    v_pk_add_f32 v[42:43], v[42:43], v[58:59]
    v_pk_add_f32 v[112:113], v[112:113], v[36:37]
    v_pk_add_f32 v[114:115], v[114:115], v[38:39]
    v_pk_add_f32 v[116:117], v[116:117], v[40:41]
    v_pk_add_f32 v[118:119], v[118:119], v[42:43]
    v_max_u32 v68, v68, v69
    v_cmp_eq_u32 vcc, -1, v68
    v_cvt_pk_bf16_f32 v108, v112, v113
    v_cvt_pk_bf16_f32 v109, v114, v115
    v_cvt_pk_bf16_f32 v110, v116, v117
    v_cvt_pk_bf16_f32 v111, v118, v119
    s_cbranch_vccnz L_fin
    global_store_dwordx4 v3, v[108:111], s[80:81]
    s_endpgm
L_far:
    global_store_dwordx2 v4, v[28:29], s[72:73] sc1
    global_store_dwordx4 v3, v[20:23], s[72:73] sc1
    global_store_dwordx4 v3, v[24:27], s[72:73] offset:1024 sc1
    s_bitcmp1_b32 s45, 0
    s_cbranch_scc1 L_look
    v_mov_b32 v148, 0
    s_waitcnt vmcnt(0)
    global_load_dword v149, v148, s[82:83] sc1
    s_waitcnt vmcnt(0)
    v_readfirstlane_b32 s43, v149
    s_nop 3
    s_and_b32 s43, s43, 7
    s_cmp_eq_u32 s43, 4
    s_cbranch_scc1 L_look
    s_endpgm
L_helper:
    v_lshlrev_b32 v3, 4, v0
    v_lshlrev_b32 v4, 3, v17
    v_add_u32 v4, 2048, v4
    v_add_u32 v162, 73984, v3
    v_mov_b32 v163, 76032
    v_lshlrev_b32 v168, 5, v17
    v_add_u32 v168, 76096, v168
    v_mov_b32 v100, -1
    v_mov_b32 v101, -1
    v_mov_b32 v102, -1
    v_mov_b32 v103, -1
    v_mov_b32 v104, 0
    v_mov_b32 v105, 0
    v_mov_b32 v106, 25
    v_mov_b32 v107, 0
    ds_write_b128 v163, v[104:107]
    s_lshl_b32 s43, s3, 10
    v_add_u32 v153, s43, v3
    s_lshl_b32 s43, s3, 8
    v_lshlrev_b32 v154, 4, v18
    v_add_u32 v154, s43, v154
    s_lshr_b32 s43, s3, 3
    s_lshl_b32 s43, s43, 1
    v_mov_b32 v155, s43
    s_lshr_b32 s43, s2, 3
    s_mul_i32 s43, s43, 4352
    s_add_u32 s43, s43, 0x100000
    v_lshrrev_b32 v166, 3, v0
    v_lshlrev_b32 v166, 9, v166
    v_and_b32 v157, 7, v0
    v_lshl_add_u32 v166, v157, 2, v166
    v_add_u32 v166, s43, v166
    s_and_b32 s44, s2, 7
    s_lshl_b32 s44, s44, 2
    s_add_u32 s43, s43, s44
    v_mov_b32 v157, s43
    s_and_b32 s43, s3, 56
    v_add_u32 v156, s43, v0
    v_lshlrev_b32 v156, 2, v156
    s_and_b32 s46, s3, 7
    s_getreg_b32 s48, hwreg(HW_REG_XCC_ID, 0, 4)
    s_mul_i32 s44, s48, s48
    s_lshl_b32 s44, s44, 12
    s_lshl_b32 s48, s48, 4
    s_or_b32 s48, s48, s44
    s_or_b32 s48, s48, 1
    v_mov_b32 v164, s48
    s_lshl_b32 s48, s48, 2
    s_lshl_b32 s43, s3, 14
    s_waitcnt lgkmcnt(0)
    s_add_u32 s44, s22, 0
    s_and_b32 s44, s44, 3
    s_lshl_b32 s44, s44, 12
    s_add_u32 s44, s44, s43
    s_add_u32 s72, s20, s44
    s_addc_u32 s73, s21, 0
    global_store_dwordx4 v3, v[100:103], s[72:73] sc1
    global_store_dwordx4 v3, v[100:103], s[72:73] offset:1024 sc1
    global_store_dwordx2 v4, v[100:101], s[72:73] sc1
    s_and_b32 s44, s2, 7
    s_cbranch_scc1 L_noclr
    s_bfm_b64 exec, 16, 0
    global_store_dword v166, v100, s[20:21] sc1
L_noclr:
    s_lshl_b32 s44, s3, 2
    s_add_u32 s82, s18, s44
    s_addc_u32 s83, s19, 0
    s_mov_b64 exec, 1
    s_waitcnt vmcnt(0)
    global_atomic_add v104, v164, s[82:83]
    s_mov_b64 exec, -1
    s_cmp_lg_u32 s22, 0
    s_cbranch_scc1 L_notree
    global_load_dwordx4 v[36:39], v153, s[4:5]
    global_load_dwordx4 v[40:43], v154, s[10:11]
    global_load_dwordx4 v[44:47], v154, s[12:13]
    global_load_ushort v48, v155, s[14:15]
    s_waitcnt vmcnt(0)
    v_lshlrev_b32 v148, 16, v36
    v_lshlrev_b32 v149, 16, v40
    v_and_b32 v150, 0xffff0000, v36
    v_and_b32 v151, 0xffff0000, v40
    v_mul_f32 v152, v148, v149
    v_fmac_f32 v152, v150, v151
    v_lshlrev_b32 v20, 16, v44
    v_and_b32 v21, 0xffff0000, v44
    v_lshlrev_b32 v148, 16, v37
    v_lshlrev_b32 v149, 16, v41
    v_and_b32 v150, 0xffff0000, v37
    v_and_b32 v151, 0xffff0000, v41
    v_fmac_f32 v152, v148, v149
    v_fmac_f32 v152, v150, v151
    v_lshlrev_b32 v22, 16, v45
    v_and_b32 v23, 0xffff0000, v45
    v_lshlrev_b32 v148, 16, v38
    v_lshlrev_b32 v149, 16, v42
    v_and_b32 v150, 0xffff0000, v38
    v_and_b32 v151, 0xffff0000, v42
    v_fmac_f32 v152, v148, v149
    v_fmac_f32 v152, v150, v151
    v_lshlrev_b32 v24, 16, v46
    v_and_b32 v25, 0xffff0000, v46
    v_lshlrev_b32 v148, 16, v39
    v_lshlrev_b32 v149, 16, v43
    v_and_b32 v150, 0xffff0000, v39
    v_and_b32 v151, 0xffff0000, v43
    v_fmac_f32 v152, v148, v149
    v_fmac_f32 v152, v150, v151
    v_lshlrev_b32 v26, 16, v47
    v_and_b32 v27, 0xffff0000, v47
    s_nop 1
    v_add_f32_dpp v152, v152, v152 row_ror:8 row_mask:0xf bank_mask:0xf
    s_nop 1
    v_add_f32_dpp v152, v152, v152 row_ror:4 row_mask:0xf bank_mask:0xf
    s_nop 1
    v_add_f32_dpp v152, v152, v152 row_ror:2 row_mask:0xf bank_mask:0xf
    s_nop 1
    v_add_f32_dpp v152, v152, v152 row_ror:1 row_mask:0xf bank_mask:0xf
    v_lshlrev_b32 v148, 16, v48
    v_sub_f32 v148, 1.0, v148
    v_mul_f32 v148, 0xceabfb8f, v148
    v_fma_f32 v28, v152, s42, v148
    s_branch L_hastree
L_notree:
    v_mov_b32 v28, 0xff800000
    v_mov_b32 v20, 0
    v_mov_b32 v21, 0
    v_mov_b32 v22, 0
    v_mov_b32 v23, 0
    v_mov_b32 v24, 0
    v_mov_b32 v25, 0
    v_mov_b32 v26, 0
    v_mov_b32 v27, 0
L_hastree:
    ds_write_b128 v162, v[20:23]
    ds_write_b128 v162, v[24:27] offset:1024
    ds_write_b32 v168, v28 offset:16
    s_mov_b32 s49, 0
    s_waitcnt vmcnt(0) lgkmcnt(0)
L_pt0:
    s_barrier
    s_bfm_b64 exec, 8, 0
    global_load_dword v149, v156, s[18:19] sc1
    s_waitcnt vmcnt(0)
    v_readlane_b32 s43, v149, s46
    v_and_b32 v149, 7, v149
    v_cmp_ne_u32 vcc, 4, v149
    s_and_b32 s44, s43, 7
    s_cmp_lg_u32 s44, 4
    s_cbranch_scc1 L_pt1
    s_cmp_eq_u32 s43, s48
    s_cselect_b32 s43, 3, 1
    v_mov_b32 v164, s43
    ds_write_b32 v163, v164 offset:4
    s_cbranch_vccnz L_pt1
    s_mov_b32 s49, 1
L_ok0:
    s_mov_b64 exec, 0xff
    global_load_dword v149, v166, s[20:21] offset:0 sc1
    s_waitcnt vmcnt(0)
    v_cmp_ne_u32 vcc, -1, v149
    s_mov_b64 exec, 1
    global_store_dword v157, v104, s[20:21] offset:0 sc1
    s_bcnt1_i32_b32 s43, vcc_lo
    s_lshl_b32 s43, s43, 2
    s_lshr_b32 s44, 0x12468adf, s43
    s_and_b32 s44, s44, 15
    s_add_u32 s44, s44, 16
    v_mov_b32 v146, s44
    ds_write_b32 v163, v146 offset:8
L_pt1:
    s_barrier
    s_cmp_lg_u32 s49, 0
    s_cbranch_scc1 L_ok1
    s_bfm_b64 exec, 8, 0
    global_load_dword v149, v156, s[18:19] sc1
    s_waitcnt vmcnt(0)
    v_readlane_b32 s43, v149, s46
    v_and_b32 v149, 7, v149
    v_cmp_ne_u32 vcc, 4, v149
    s_and_b32 s44, s43, 7
    s_cmp_lg_u32 s44, 4
    s_cbranch_scc1 L_fin
    s_cmp_eq_u32 s43, s48
    s_cselect_b32 s43, 3, 1
    v_mov_b32 v164, s43
    ds_write_b32 v163, v164 offset:4
    s_cbranch_vccnz L_fin
    s_mov_b32 s49, 1
L_ok1:
    s_mov_b64 exec, 0xff
    global_load_dword v149, v166, s[20:21] offset:512 sc1
    s_waitcnt vmcnt(0)
    v_cmp_ne_u32 vcc, -1, v149
    s_mov_b64 exec, 1
    global_store_dword v157, v104, s[20:21] offset:512 sc1
    s_bcnt1_i32_b32 s43, vcc_lo
    s_lshl_b32 s43, s43, 2
    s_lshr_b32 s44, 0x12344566, s43
    s_and_b32 s44, s44, 15
    s_add_u32 s44, s44, 22
    v_mov_b32 v146, s44
    ds_write_b32 v163, v146 offset:8
L_fin:
L_end:
    s_endpgm
.section .rodata,"a"
.p2align 6
.amdhsa_kernel standalone__tree_speculative_verify_tree_attention_over_candidate_token_tree__decode_kernel
  .amdhsa_next_free_vgpr 172
  .amdhsa_next_free_sgpr 88
  .amdhsa_accum_offset 172
  .amdhsa_group_segment_fixed_size 0
  .amdhsa_kernarg_size 72
  .amdhsa_user_sgpr_count 2
  .amdhsa_user_sgpr_kernarg_segment_ptr 1
  .amdhsa_system_sgpr_workgroup_id_x 1
  .amdhsa_float_denorm_mode_32 3
.end_amdhsa_kernel
```
